```python
import torch

def _softmax(x, axis=-1):
    return torch.softmax(x, dim=axis)
def _gelu(x):
    return torch.nn.functional.gelu(x, approximate="tanh")
def _silu(x):
    return torch.nn.functional.silu(x)
def _sigmoid(x):
    return torch.sigmoid(x)
def _layernorm(x, axis=-1, eps=1e-5):
    m = x.mean(dim=axis, keepdim=True)
    v = x.var(dim=axis, keepdim=True, unbiased=False)
    return (x - m) / torch.sqrt(v + eps)
def _scatter_add(tgt, idx, src, axis=0):
    return tgt.clone().index_add_(axis, idx, src)
def _segment_sum(src, seg, n):
    out = torch.zeros((n,) + src.shape[1:], dtype=src.dtype)
    return out.index_add_(0, seg, src)
def _pad(x, pw):
    flat = tuple(v for pair in reversed(pw) for v in pair)
    return torch.nn.functional.pad(x, flat)

kernel_name = 'parallel_sum__sliding_block_cached__dense_activation_relu__decode'

def setup_inputs():

    _w = (lambda a: (lambda t: t.to(torch.bfloat16) if t.is_floating_point() else t)(torch.as_tensor(a)))
    def _A_setup():
        B, Sq, D = 1, 1, 512
        Hq, Hkv, Sk, Dh = 32, 8, 65536, 128
        assert Hq % Hkv == 0, (Hq, Hkv)
        return {
            "x": _w((lambda *s: torch.randn(*s, dtype=torch.bfloat16) * 0.05)(B, Sq, D)),
            "k_cache": _w((lambda *s: torch.randn(*s, dtype=torch.bfloat16) * 3.2)(B, Hkv, Sk, Dh)),
            "v_cache": _w((lambda *s: torch.randn(*s, dtype=torch.bfloat16) * 1.6)(B, Hkv, Sk, Dh)),
            "wq": _w((lambda *s: torch.randn(*s, dtype=torch.bfloat16) * 3.2)(D, Hq * Dh) * (D ** -0.5)),
            "wo": _w((lambda *s: torch.randn(*s, dtype=torch.bfloat16) * 1.6)(Hq * Dh, D) * ((Hq * Dh) ** -0.5)),
        }
    _A_in = _A_setup()

    def _B_setup():
        B, S, D, Dff = 1, 1, 512, 1792
        return {
            "x": _w((lambda *s: torch.randn(*s, dtype=torch.bfloat16) * 0.05)(B, S, D)),
            "w1": _w((lambda *s: torch.randn(*s, dtype=torch.bfloat16) * 0.05)(D, Dff)),
            "w2": _w((lambda *s: torch.randn(*s, dtype=torch.bfloat16) * 0.05)(Dff, D)),
        }
    _B_in = _B_setup()

    return {
        "A_x": _A_in["x"],
        "A_k_cache": _A_in["k_cache"],
        "A_v_cache": _A_in["v_cache"],
        "A_wq": _A_in["wq"],
        "A_wo": _A_in["wo"],
        "B_x": _B_in["x"],
        "B_w1": _B_in["w1"],
        "B_w2": _B_in["w2"],
    }

def reference(A_x, A_k_cache, A_v_cache, A_wq, A_wo, B_x, B_w1, B_w2):
    def _A_ref(x, k_cache, v_cache, wq, wo):
        B, Sq, D = x.shape
        Hq, Dh = 32, 128
        Hkv, Sk = k_cache.shape[1], k_cache.shape[2]
        W = min(4096, max(256, Sk // 4))
        rep = Hq // Hkv
        q = (lambda x, *d: x.permute(*d))((x @ wq).reshape(B, Sq, Hq, Dh), 0, 2, 1, 3)
        k = (lambda x, n, axis: torch.repeat_interleave(x, n, dim=axis))(k_cache[:, :, Sk - W:, :], rep, axis=1)
        v = (lambda x, n, axis: torch.repeat_interleave(x, n, dim=axis))(v_cache[:, :, Sk - W:, :], rep, axis=1)
        scores = torch.einsum("bhqd,bhkd->bhqk", q, k) * (Dh ** -0.5)
        p = _softmax(scores, axis=-1)
        o = torch.einsum("bhqk,bhkd->bhqd", p, v)
        return (lambda x, *d: x.permute(*d))(o, 0, 2, 1, 3).reshape(B, Sq, Hq * Dh) @ wo

    def _B_ref(x, w1, w2):
        h = torch.einsum("bsd,df->bsf", x, w1)
        zero = torch.zeros_like(h)
        h = torch.maximum(h, zero)
        return torch.einsum("bsf,fd->bsd", h, w2)

    x = A_x
    xn = _layernorm(x, axis=-1)
    return x + _A_ref(xn, A_k_cache, A_v_cache, A_wq, A_wo) + _B_ref(xn, B_w1, B_w2)
```

```asm
; @launch grid=(256,1,1) block=(576,1,1) lds=90112
.amdgcn_target "amdgcn-amd-amdhsa--gfx950"
.text
.globl parallel_sum__sliding_block_cached__dense_activation_relu__decode_kernel
.p2align 8
.type parallel_sum__sliding_block_cached__dense_activation_relu__decode_kernel,@function
parallel_sum__sliding_block_cached__dense_activation_relu__decode_kernel:
    s_cmp_ge_u32 s2, 256
    s_cbranch_scc1 L_end
    s_load_dwordx16 s[4:19], s[0:1], 0
    s_load_dwordx4 s[20:23], s[0:1], 64
    s_load_dwordx2 s[24:25], s[0:1], 80
    v_and_b32 v1, 63, v0
    v_lshrrev_b32 v2, 6, v0
    s_nop 0
    v_readfirstlane_b32 s26, v2
    s_and_b32 s27, s2, 7
    s_lshr_b32 s28, s2, 3
    v_lshlrev_b32 v120, 4, v1
    v_lshrrev_b32 v8, 3, v1
    v_and_b32 v9, 7, v1
    v_lshlrev_b32 v121, 14, v8
    v_lshl_add_u32 v121, v9, 4, v121
    v_mov_b32 v10, 0x1800000
    v_and_b32 v11, 15, v1
    v_lshrrev_b32 v12, 4, v1
    v_lshlrev_b32 v123, 19, v12
    v_lshl_add_u32 v123, v11, 4, v123
    s_and_b32 s49, s28, 7
    s_lshr_b32 s49, s49, 1
    s_lshl_b32 s49, s49, 2
    s_lshr_b32 s55, s28, 3
    s_add_u32 s49, s49, s55
    s_lshl_b32 s49, s49, 9
    s_and_b32 s55, s28, 1
    s_lshl_b32 s55, s55, 8
    s_add_u32 s62, s49, s55
    s_lshr_b32 s49, s28, 3
    s_lshl_b32 s49, s49, 7
    s_lshl_b32 s55, s26, 4
    s_add_u32 s49, s49, s55
    s_lshl_b32 s49, s49, 13
    s_lshl_b32 s55, s27, 10
    s_add_u32 s49, s49, s55
    s_and_b32 s55, s28, 7
    s_lshl_b32 s55, s55, 7
    s_add_u32 s49, s49, s55
    s_lshl_b32 s55, s27, 16
    s_waitcnt lgkmcnt(0)
    s_getreg_b32 s14, hwreg(HW_REG_XCC_ID, 0, 3)
    s_add_u32 s56, s24, s55
    s_addc_u32 s57, s25, 0
    s_add_u32 s64, s10, s49
    s_addc_u32 s65, s11, 0
    s_add_u32 s66, s64, 8192
    s_addc_u32 s67, s65, 0
    global_load_dword v27, v10, s[24:25]
    s_cmp_eq_u32 s26, 8
    s_cbranch_scc1 L_nold
    global_load_dwordx4 v[20:23], v120, s[4:5]
    global_load_dwordx4 v[28:31], v121, s[64:65] nt
    global_load_dwordx4 v[32:35], v121, s[66:67] nt
L_nold:
    s_nop 7
    v_lshlrev_b32 v124, 8, v11
    v_lshl_add_u32 v124, v12, 4, v124
    s_lshl_b32 s50, s27, 24
    s_add_u32 s50, s50, 0xf00000
    s_lshl_b32 s55, s28, 15
    s_add_u32 s50, s50, s55
    s_lshl_b32 s55, s26, 12
    s_add_u32 s50, s50, s55
    s_add_u32 s36, s6, s50
    s_addc_u32 s37, s7, 0
    s_add_u32 s38, s8, s50
    s_addc_u32 s39, s9, 0
    s_add_u32 s58, s56, 32768
    s_addc_u32 s59, s57, 0
    s_mov_b32 s46, 0x05040100
    s_mov_b32 s47, 0x07060302
    s_mov_b32 s53, 0x3fb8aa3b
    s_mov_b32 s54, 0x3db504f3
    s_mov_b32 s52, 0
    s_mul_i32 s29, s27, 28
    s_add_u32 s29, s29, s28
    s_cmp_lt_u32 s28, 28
    s_cselect_b32 s29, s29, 0
    s_cselect_b32 s48, -1, 0
    s_lshl_b32 s49, s2, 16
    s_add_u32 s30, s24, s49
    s_addc_u32 s31, s25, 0
    s_add_u32 s32, s30, 4096
    s_addc_u32 s33, s31, 0
    s_add_u32 s34, s30, 32768
    s_addc_u32 s35, s31, 0
    s_add_u32 s60, s30, 36864
    s_addc_u32 s61, s31, 0
    s_mul_i32 s49, s26, 229376
    s_lshl_b32 s55, s29, 4
    s_add_u32 s49, s49, s55
    s_add_u32 s44, s16, s49
    s_addc_u32 s45, s17, 0
    v_and_b32 v8, 31, v1
    v_lshrrev_b32 v9, 5, v1
    v_lshl_add_u32 v10, v8, 1, v9
    s_movk_i32 s55, 3584
    v_mul_lo_u32 v122, v10, s55
    s_lshl_b32 s49, s27, 2
    s_lshr_b32 s55, s28, 3
    s_add_u32 s49, s49, s55
    s_lshl_b32 s49, s49, 7
    s_and_b32 s55, s28, 7
    s_lshl_b32 s55, s55, 4
    s_add_u32 s49, s49, s55
    s_lshl_b32 s55, s26, 1
    s_add_u32 s49, s49, s55
    s_lshl_b32 s49, s49, 10
    s_add_u32 s40, s12, s49
    s_addc_u32 s41, s13, 0
    s_lshl_b32 s49, s29, 3
    s_add_u32 s49, s49, s26
    s_lshl_b32 s49, s49, 10
    s_add_u32 s42, s18, s49
    s_addc_u32 s43, s19, 0
    v_lshlrev_b32 v125, 2, v1
    v_lshlrev_b32 v130, 7, v8
    s_lshl_b32 s49, s26, 3
    v_add_u32 v131, s49, v130
    s_lshl_b32 s49, s28, 3
    s_and_b32 s55, s28, 7
    s_add_u32 s49, s49, s55
    s_lshl_b32 s3, s49, 16
    v_min_u32 v13, 8, v11
    v_lshlrev_b32 v14, 8, v12
    v_lshl_add_u32 v14, v13, 4, v14
    v_add_u32 v134, 8192, v14
    v_lshlrev_b32 v14, 7, v12
    v_lshl_add_u32 v133, v13, 3, v14
    v_add_u32 v135, 16384, v120
    v_lshlrev_b32 v132, 3, v1
    v_add_u32 v126, 4096, v120
    s_mov_b64 s[16:17], -1
    s_cmp_eq_u32 s26, 8
    s_cbranch_scc1 L_comm
    s_mov_b32 s19, 0
    s_mov_b32 s18, s26
    s_mov_b64 s[16:17], 0
    s_mov_b64 exec, 0
    s_mov_b32 s26, 0
    s_cmp_eq_u32 s18, 1
    s_cbranch_scc1 L_secA1
    s_cmp_eq_u32 s18, 2
    s_cbranch_scc1 L_secA2
    s_cmp_eq_u32 s18, 3
    s_cbranch_scc1 L_secA3
    s_cmp_eq_u32 s18, 4
    s_cbranch_scc1 L_secA4
    s_cmp_eq_u32 s18, 5
    s_cbranch_scc1 L_secA5
    s_cmp_eq_u32 s18, 6
    s_cbranch_scc1 L_sec1
    s_cmp_eq_u32 s18, 7
    s_cbranch_scc1 L_secA7
    s_branch L_sec0
L_dry_done:
    s_nop 7
    s_mov_b64 s[16:17], -1
    s_mov_b64 exec, -1
    s_mov_b32 s26, s18
    s_mov_b32 s52, 0
    s_cmp_eq_u32 s19, 1
    s_cbranch_scc1 L_retB
L_sec0:
    s_cbranch_execz L_g1
    s_waitcnt vmcnt(2)
    global_load_dwordx4 v[40:43], v124, s[36:37] offset:0 nt
    global_load_dwordx4 v[44:47], v124, s[36:37] offset:64 nt
    global_load_dwordx4 v[48:51], v124, s[36:37] offset:128 nt
    global_load_dwordx4 v[52:55], v124, s[36:37] offset:192 nt
L_g1:
    v_readfirstlane_b32 s22, v27
    s_nop 1
    s_add_u32 s22, s22, 1
    s_xor_b32 s23, s22, 0xa5c3a5c0
    s_xor_b32 s15, s23, s14
    v_mov_b32 v138, s22
    v_mov_b32 v139, s23
    v_lshlrev_b32 v2, 16, v20
    v_and_b32 v3, 0xffff0000, v20
    v_lshlrev_b32 v4, 16, v21
    v_and_b32 v5, 0xffff0000, v21
    v_lshlrev_b32 v6, 16, v22
    v_and_b32 v7, 0xffff0000, v22
    v_lshlrev_b32 v8, 16, v23
    v_and_b32 v9, 0xffff0000, v23
    v_add_f32 v10, v2, v3
    v_add_f32 v11, v4, v5
    v_add_f32 v12, v6, v7
    v_add_f32 v13, v8, v9
    v_add_f32 v10, v10, v11
    v_add_f32 v12, v12, v13
    v_add_f32 v10, v10, v12
    s_cbranch_execz L_dry_done
L_secA1:
    s_nop 0
    v_add_f32_dpp v10, v10, v10 quad_perm:[1,0,3,2] row_mask:0xf bank_mask:0xf
    s_nop 1
    v_add_f32_dpp v10, v10, v10 quad_perm:[2,3,0,1] row_mask:0xf bank_mask:0xf
    s_nop 1
    v_add_f32_dpp v10, v10, v10 row_half_mirror row_mask:0xf bank_mask:0xf
    s_nop 1
    v_add_f32_dpp v10, v10, v10 row_mirror row_mask:0xf bank_mask:0xf
    v_mov_b32 v11, v10
    s_nop 1
    v_permlane16_swap_b32 v10, v11
    v_add_f32 v10, v10, v11
    v_mov_b32 v11, v10
    s_nop 1
    v_permlane32_swap_b32 v10, v11
    v_add_f32 v10, v10, v11
    v_mul_f32 v10, 0x3b000000, v10
    v_sub_f32 v11, v2, v10
    v_mul_f32 v12, v11, v11
    v_sub_f32 v11, v3, v10
    v_fmac_f32 v12, v11, v11
    v_sub_f32 v11, v4, v10
    v_fmac_f32 v12, v11, v11
    v_sub_f32 v11, v5, v10
    v_fmac_f32 v12, v11, v11
    v_sub_f32 v11, v6, v10
    v_fmac_f32 v12, v11, v11
    v_sub_f32 v11, v7, v10
    v_fmac_f32 v12, v11, v11
    v_sub_f32 v11, v8, v10
    v_fmac_f32 v12, v11, v11
    v_sub_f32 v11, v9, v10
    v_fmac_f32 v12, v11, v11
    s_cbranch_execz L_dry_done
L_secA2:
    s_nop 0
    v_add_f32_dpp v12, v12, v12 quad_perm:[1,0,3,2] row_mask:0xf bank_mask:0xf
    s_nop 1
    v_add_f32_dpp v12, v12, v12 quad_perm:[2,3,0,1] row_mask:0xf bank_mask:0xf
    s_nop 1
    v_add_f32_dpp v12, v12, v12 row_half_mirror row_mask:0xf bank_mask:0xf
    s_nop 1
    v_add_f32_dpp v12, v12, v12 row_mirror row_mask:0xf bank_mask:0xf
    v_mov_b32 v11, v12
    s_nop 1
    v_permlane16_swap_b32 v12, v11
    v_add_f32 v12, v12, v11
    v_mov_b32 v11, v12
    s_nop 1
    v_permlane32_swap_b32 v12, v11
    v_add_f32 v12, v12, v11
    v_mul_f32 v12, 0x3b000000, v12
    v_cvt_pk_bf16_f32 v11, v10, v10
    v_lshlrev_b32 v10, 16, v11
    v_cvt_pk_bf16_f32 v11, v12, v12
    v_lshlrev_b32 v12, 16, v11
    v_add_f32 v12, 0x3727c5ac, v12
    v_cvt_pk_bf16_f32 v11, v12, v12
    v_lshlrev_b32 v12, 16, v11
    s_cbranch_execz L_dry_done
L_secA3:
    v_sqrt_f32 v12, v12
    s_nop 0
    v_cvt_pk_bf16_f32 v11, v12, v12
    v_lshlrev_b32 v12, 16, v11
    v_rcp_f32 v13, v12
    s_nop 0
    v_fma_f32 v11, -v12, v13, 1.0
    v_fma_f32 v13, v11, v13, v13
    v_sub_f32 v2, v2, v10
    v_sub_f32 v3, v3, v10
    v_sub_f32 v4, v4, v10
    v_sub_f32 v5, v5, v10
    v_sub_f32 v6, v6, v10
    v_sub_f32 v7, v7, v10
    v_sub_f32 v8, v8, v10
    v_sub_f32 v9, v9, v10
    v_cvt_pk_bf16_f32 v14, v2, v3
    v_cvt_pk_bf16_f32 v15, v4, v5
    v_cvt_pk_bf16_f32 v16, v6, v7
    v_cvt_pk_bf16_f32 v17, v8, v9
    v_lshlrev_b32 v2, 16, v14
    v_and_b32 v3, 0xffff0000, v14
    v_lshlrev_b32 v4, 16, v15
    v_and_b32 v5, 0xffff0000, v15
    v_lshlrev_b32 v6, 16, v16
    v_and_b32 v7, 0xffff0000, v16
    v_lshlrev_b32 v8, 16, v17
    v_and_b32 v9, 0xffff0000, v17
    s_cbranch_execz L_dry_done
L_secA4:
    v_mul_f32 v2, v2, v13
    v_mul_f32 v3, v3, v13
    v_mul_f32 v4, v4, v13
    v_mul_f32 v5, v5, v13
    v_mul_f32 v6, v6, v13
    v_mul_f32 v7, v7, v13
    v_mul_f32 v8, v8, v13
    v_mul_f32 v9, v9, v13
    v_cvt_pk_bf16_f32 v14, v2, v3
    v_cvt_pk_bf16_f32 v15, v4, v5
    v_cvt_pk_bf16_f32 v16, v6, v7
    v_cvt_pk_bf16_f32 v17, v8, v9
    ds_write_b128 v120, v[14:17] offset:0
    v_lshrrev_b32 v2, 3, v1
    s_lshr_b32 s49, s28, 3
    s_lshl_b32 s49, s49, 6
    s_lshl_b32 s55, s26, 3
    s_add_u32 s49, s49, s55
    v_add_lshl_u32 v2, v2, s49, 2
    v_and_b32 v3, 31, v1
    s_lshl_b32 s49, s26, 5
    v_add_lshl_u32 v3, v3, s49, 2
    s_waitcnt lgkmcnt(0)
    ds_read_b32 v25, v2 offset:0
    ds_read_b32 v26, v3 offset:0
    s_cbranch_execz L_dry_done
L_sec1:
    s_cbranch_execz L_g2
    s_waitcnt vmcnt(4) lgkmcnt(0)
L_g2:
    v_perm_b32 v2, v32, v28, s46
    v_perm_b32 v3, v32, v28, s47
    v_perm_b32 v4, v33, v29, s46
    v_perm_b32 v5, v33, v29, s47
    v_perm_b32 v6, v34, v30, s46
    v_perm_b32 v7, v34, v30, s47
    v_perm_b32 v8, v35, v31, s46
    v_perm_b32 v9, v35, v31, s47
    v_dot2_f32_bf16 v104, v2, v25, 0
    v_dot2_f32_bf16 v105, v3, v25, 0
    v_dot2_f32_bf16 v106, v4, v25, 0
    v_dot2_f32_bf16 v107, v5, v25, 0
    v_dot2_f32_bf16 v108, v6, v25, 0
    v_dot2_f32_bf16 v109, v7, v25, 0
    v_dot2_f32_bf16 v110, v8, v25, 0
    v_dot2_f32_bf16 v111, v9, v25, 0
    v_add_f32_dpp v104, v104, v104 row_ror:8 row_mask:0xf bank_mask:0xf
    v_add_f32_dpp v105, v105, v105 row_ror:8 row_mask:0xf bank_mask:0xf
    v_add_f32_dpp v106, v106, v106 row_ror:8 row_mask:0xf bank_mask:0xf
    v_add_f32_dpp v107, v107, v107 row_ror:8 row_mask:0xf bank_mask:0xf
    v_add_f32_dpp v108, v108, v108 row_ror:8 row_mask:0xf bank_mask:0xf
    v_add_f32_dpp v109, v109, v109 row_ror:8 row_mask:0xf bank_mask:0xf
    v_add_f32_dpp v110, v110, v110 row_ror:8 row_mask:0xf bank_mask:0xf
    v_add_f32_dpp v111, v111, v111 row_ror:8 row_mask:0xf bank_mask:0xf
    s_cbranch_execz L_dry_done
L_secA5:
    v_mov_b32 v2, v104
    v_mov_b32 v3, v105
    v_mov_b32 v4, v106
    v_mov_b32 v5, v107
    v_mov_b32 v6, v108
    v_mov_b32 v7, v109
    v_mov_b32 v8, v110
    v_mov_b32 v9, v111
    v_permlane16_swap_b32 v104, v2
    v_permlane16_swap_b32 v105, v3
    v_permlane16_swap_b32 v106, v4
    v_permlane16_swap_b32 v107, v5
    v_permlane16_swap_b32 v108, v6
    v_permlane16_swap_b32 v109, v7
    v_permlane16_swap_b32 v110, v8
    v_permlane16_swap_b32 v111, v9
    v_add_f32 v104, v104, v2
    v_add_f32 v105, v105, v3
    v_add_f32 v106, v106, v4
    v_add_f32 v107, v107, v5
    v_add_f32 v108, v108, v6
    v_add_f32 v109, v109, v7
    v_add_f32 v110, v110, v8
    v_add_f32 v111, v111, v9
    v_mov_b32 v2, v104
    v_mov_b32 v3, v105
    v_mov_b32 v4, v106
    v_mov_b32 v5, v107
    v_mov_b32 v6, v108
    v_mov_b32 v7, v109
    v_mov_b32 v8, v110
    v_mov_b32 v9, v111
    v_permlane32_swap_b32 v104, v2
    v_permlane32_swap_b32 v105, v3
    v_permlane32_swap_b32 v106, v4
    v_permlane32_swap_b32 v107, v5
    v_permlane32_swap_b32 v108, v6
    v_permlane32_swap_b32 v109, v7
    v_permlane32_swap_b32 v110, v8
    v_permlane32_swap_b32 v111, v9
    v_add_f32 v104, v104, v2
    v_add_f32 v105, v105, v3
    v_add_f32 v106, v106, v4
    v_add_f32 v107, v107, v5
    v_add_f32 v108, v108, v6
    v_add_f32 v109, v109, v7
    v_add_f32 v110, v110, v8
    v_add_f32 v111, v111, v9
    v_lshlrev_b32 v3, 5, v1
    s_lshl_b32 s49, s26, 8
    v_add_u32 v3, s49, v3
    s_and_b32 exec_lo, s16, 0xff
    s_and_b32 exec_hi, s17, 0x0
    ds_write_b128 v3, v[104:107] offset:1024
    ds_write_b128 v3, v[108:111] offset:1040
    s_mov_b64 exec, s[16:17]
    s_waitcnt lgkmcnt(0)
    s_cbranch_execz L_g3
    s_barrier
L_g3:
    s_cbranch_execz L_dry_done
L_secA7:
    s_cmp_lg_u32 s26, 0
    s_cbranch_scc1 L_noq
    ds_read_b32 v2, v125 offset:1024
    ds_read_b32 v3, v125 offset:1280
    ds_read_b32 v4, v125 offset:1536
    ds_read_b32 v5, v125 offset:1792
    ds_read_b32 v6, v125 offset:2048
    ds_read_b32 v7, v125 offset:2304
    ds_read_b32 v8, v125 offset:2560
    ds_read_b32 v9, v125 offset:2816
    s_waitcnt lgkmcnt(0)
    v_add_f32 v2, v2, v3
    v_add_f32 v4, v4, v5
    v_add_f32 v6, v6, v7
    v_add_f32 v8, v8, v9
    v_add_f32 v2, v2, v4
    v_add_f32 v6, v6, v8
    v_add_f32 v2, v2, v6
    s_nop 1
    v_mov_b32_dpp v3, v2 quad_perm:[1,0,3,2] row_mask:0xf bank_mask:0xf
    v_cvt_pk_bf16_f32 v4, v2, v3
    v_lshlrev_b32 v5, 1, v1
    s_and_b32 exec_lo, s16, 0x55555555
    s_and_b32 exec_hi, s17, 0x55555555
    ds_write_b32 v5, v4 offset:3072
    s_mov_b64 exec, s[16:17]
    v_and_b32 v6, 15, v1
    v_lshlrev_b32 v7, 3, v6
    s_waitcnt lgkmcnt(0)
    ds_read_b64 v[136:137], v7 offset:3072
    v_add_u32 v3, s62, v120
    v_mov_b32 v139, s15
    s_waitcnt lgkmcnt(0)
    s_and_b32 exec_lo, s16, 0xffff
    s_and_b32 exec_hi, s17, 0x0
    s_cbranch_execz L_g4
    global_store_dwordx4 v3, v[136:139], s[56:57]
L_g4:
    s_mov_b64 exec, s[16:17]
L_noq:
    s_nop 7
    s_cbranch_execz L_dry_done
L_sec2:
    s_cbranch_execz L_g5
    s_barrier
    global_load_dword v56, v125, s[38:39] offset:0 nt
    global_load_dword v57, v125, s[38:39] offset:256 nt
    global_load_dword v58, v125, s[38:39] offset:512 nt
    global_load_dword v59, v125, s[38:39] offset:768 nt
    global_load_dword v60, v125, s[38:39] offset:1024 nt
    global_load_dword v61, v125, s[38:39] offset:1280 nt
    global_load_dword v62, v125, s[38:39] offset:1536 nt
    global_load_dword v63, v125, s[38:39] offset:1792 nt
    global_load_dword v64, v125, s[38:39] offset:2048 nt
    global_load_dword v65, v125, s[38:39] offset:2304 nt
    global_load_dword v66, v125, s[38:39] offset:2560 nt
    global_load_dword v67, v125, s[38:39] offset:2816 nt
    global_load_dword v68, v125, s[38:39] offset:3072 nt
    global_load_dword v69, v125, s[38:39] offset:3328 nt
    global_load_dword v70, v125, s[38:39] offset:3584 nt
    global_load_dword v71, v125, s[38:39] offset:3840 nt
L_g5:
    s_cmp_lg_u32 s26, 0
    s_cbranch_scc1 L_noqa
    s_and_b32 exec_lo, s16, 0xffff
    s_and_b32 exec_hi, s17, 0x0
    s_cbranch_execz L_g6
    global_store_dwordx4 v3, v[136:139], s[58:59] sc1
L_g6:
    s_mov_b64 exec, s[16:17]
    s_nop 1
    v_mov_b32 v139, s23
L_noqa:
    s_nop 7
    s_cbranch_execz L_dry_done
    s_mov_b32 s19, 1
    s_mov_b32 s18, s26
    s_mov_b64 s[16:17], 0
    s_mov_b64 exec, 0
    s_mov_b32 s26, 0
    s_cmp_eq_u32 s18, 1
    s_cbranch_scc1 L_sec3
    s_cmp_eq_u32 s18, 2
    s_cbranch_scc1 L_sec4
    s_cmp_eq_u32 s18, 3
    s_cbranch_scc1 L_sec5
    s_cmp_eq_u32 s18, 4
    s_cbranch_scc1 L_sec6
    s_cmp_eq_u32 s18, 5
    s_cbranch_scc1 L_secB5
    s_cmp_eq_u32 s18, 6
    s_cbranch_scc1 L_sec7
    s_cmp_eq_u32 s18, 7
    s_cbranch_scc1 L_secB7
    s_branch L_secB0
L_retB:
    s_nop 7
    s_cmp_lg_u32 s26, 0
    s_cbranch_scc1 L_noqc
    s_cbranch_execz L_g7
    s_waitcnt vmcnt(17)
L_g7:
    s_branch L_noqb
L_noqc:
    s_nop 7
    s_cbranch_execz L_g8
    s_waitcnt vmcnt(16)
L_g8:
L_noqb:
    s_nop 7
L_secB0:
    s_cbranch_execz L_g9
    s_barrier
    s_barrier
    global_load_dwordx4 v[36:39], v122, s[44:45]
    global_load_dwordx4 v[72:75], v120, s[40:41] nt
    global_load_dwordx4 v[76:79], v120, s[40:41] offset:1024 nt
    global_load_dwordx4 v[80:83], v120, s[42:43] nt
    s_barrier
L_g9:
    ds_read_b128 v[84:87], v124 offset:53248
    ds_read_b128 v[88:91], v124 offset:53312
    ds_read_b128 v[92:95], v124 offset:53376
    ds_read_b128 v[96:99], v124 offset:53440
    v_mov_b32 v2, 0
    ds_read_b32 v2, v2 offset:3200
    s_waitcnt lgkmcnt(0)
    v_readfirstlane_b32 s63, v2
    v_mfma_f32_16x16x32_bf16 v[100:103], v[40:43], v[84:87], 0
    v_mfma_f32_16x16x32_bf16 v[100:103], v[44:47], v[88:91], v[100:103]
    v_mfma_f32_16x16x32_bf16 v[100:103], v[48:51], v[92:95], v[100:103]
    v_mfma_f32_16x16x32_bf16 v[100:103], v[52:55], v[96:99], v[100:103]
    s_nop 7
    v_add_f32_dpp v100, v100, v100 quad_perm:[1,0,3,2] row_mask:0xf bank_mask:0xf
    v_add_f32_dpp v101, v101, v101 quad_perm:[1,0,3,2] row_mask:0xf bank_mask:0xf
    v_add_f32_dpp v102, v102, v102 quad_perm:[1,0,3,2] row_mask:0xf bank_mask:0xf
    v_add_f32_dpp v103, v103, v103 quad_perm:[1,0,3,2] row_mask:0xf bank_mask:0xf
    v_add_f32_dpp v100, v100, v100 quad_perm:[2,3,0,1] row_mask:0xf bank_mask:0xf
    v_add_f32_dpp v101, v101, v101 quad_perm:[2,3,0,1] row_mask:0xf bank_mask:0xf
    v_add_f32_dpp v102, v102, v102 quad_perm:[2,3,0,1] row_mask:0xf bank_mask:0xf
    v_add_f32_dpp v103, v103, v103 quad_perm:[2,3,0,1] row_mask:0xf bank_mask:0xf
    v_cvt_pk_bf16_f32 v2, v100, v101
    v_cvt_pk_bf16_f32 v3, v102, v103
    v_lshlrev_b32 v100, 16, v2
    v_and_b32 v101, 0xffff0000, v2
    v_lshlrev_b32 v102, 16, v3
    v_and_b32 v103, 0xffff0000, v3
    v_mul_f32 v100, s54, v100
    v_mul_f32 v101, s54, v101
    v_mul_f32 v102, s54, v102
    v_mul_f32 v103, s54, v103
    v_cvt_pk_bf16_f32 v2, v100, v101
    v_cvt_pk_bf16_f32 v3, v102, v103
    v_lshlrev_b32 v100, 16, v2
    v_and_b32 v101, 0xffff0000, v2
    v_lshlrev_b32 v102, 16, v3
    v_and_b32 v103, 0xffff0000, v3
    v_max3_f32 v4, v100, v101, v102
    v_max_f32 v4, v4, v103
    v_mov_b32 v6, v4
    s_nop 1
    v_permlane16_swap_b32 v4, v6
    v_max_f32 v4, v4, v6
    v_mov_b32 v6, v4
    s_nop 1
    v_permlane32_swap_b32 v4, v6
    v_max_f32 v4, v4, v6
    v_sub_f32 v100, v100, v4
    v_sub_f32 v101, v101, v4
    v_sub_f32 v102, v102, v4
    v_sub_f32 v103, v103, v4
    v_mul_f32 v100, s53, v100
    v_mul_f32 v101, s53, v101
    v_mul_f32 v102, s53, v102
    v_mul_f32 v103, s53, v103
    v_exp_f32 v100, v100
    v_exp_f32 v101, v101
    v_exp_f32 v102, v102
    v_exp_f32 v103, v103
    v_add_f32 v5, v100, v101
    v_add_f32 v6, v102, v103
    v_cvt_pk_bf16_f32 v8, v100, v101
    v_cvt_pk_bf16_f32 v9, v102, v103
    v_add_f32 v5, v5, v6
    v_mov_b32 v6, v5
    s_nop 1
    v_permlane16_swap_b32 v5, v6
    v_add_f32 v5, v5, v6
    v_mov_b32 v6, v5
    s_nop 1
    v_permlane32_swap_b32 v5, v6
    v_add_f32 v5, v5, v6
    v_readlane_b32 s68, v8, 0
    v_readlane_b32 s69, v9, 0
    v_readlane_b32 s70, v8, 16
    v_readlane_b32 s71, v9, 16
    v_readlane_b32 s72, v8, 32
    v_readlane_b32 s73, v9, 32
    v_readlane_b32 s74, v8, 48
    v_readlane_b32 s75, v9, 48
    v_readlane_b32 s76, v8, 4
    v_readlane_b32 s77, v9, 4
    v_readlane_b32 s78, v8, 20
    v_readlane_b32 s79, v9, 20
    v_readlane_b32 s80, v8, 36
    v_readlane_b32 s81, v9, 36
    v_readlane_b32 s82, v8, 52
    v_readlane_b32 s83, v9, 52
    v_readlane_b32 s84, v8, 8
    v_readlane_b32 s85, v9, 8
    v_readlane_b32 s86, v8, 24
    v_readlane_b32 s87, v9, 24
    v_readlane_b32 s88, v8, 40
    v_readlane_b32 s89, v9, 40
    v_readlane_b32 s90, v8, 56
    v_readlane_b32 s91, v9, 56
    v_readlane_b32 s92, v8, 12
    v_readlane_b32 s93, v9, 12
    v_readlane_b32 s94, v8, 28
    v_readlane_b32 s95, v9, 28
    v_readlane_b32 s96, v8, 44
    v_readlane_b32 s97, v9, 44
    v_readlane_b32 s98, v8, 60
    v_readlane_b32 s99, v9, 60
    v_lshlrev_b32 v10, 1, v1
    s_lshl_b32 s49, s26, 5
    v_add_u32 v10, s49, v10
    s_and_b32 exec_lo, s16, 0x1111
    s_and_b32 exec_hi, s17, 0x0
    ds_write_b64 v10, v[4:5] offset:3584
    s_mov_b64 exec, s[16:17]
    s_cbranch_execz L_dry_done
L_sec3:
    s_cbranch_execz L_g10
    s_waitcnt vmcnt(12)
L_g10:
    v_perm_b32 v12, v57, v56, s46
    v_perm_b32 v13, v57, v56, s47
    v_dot2_f32_bf16 v104, v12, s68, 0
    v_dot2_f32_bf16 v105, v13, s68, 0
    v_dot2_f32_bf16 v106, v12, s76, 0
    v_dot2_f32_bf16 v107, v13, s76, 0
    v_dot2_f32_bf16 v108, v12, s84, 0
    v_dot2_f32_bf16 v109, v13, s84, 0
    v_dot2_f32_bf16 v110, v12, s92, 0
    v_dot2_f32_bf16 v111, v13, s92, 0
    v_perm_b32 v12, v59, v58, s46
    v_perm_b32 v13, v59, v58, s47
    v_dot2_f32_bf16 v104, v12, s69, v104
    v_dot2_f32_bf16 v105, v13, s69, v105
    v_dot2_f32_bf16 v106, v12, s77, v106
    v_dot2_f32_bf16 v107, v13, s77, v107
    v_dot2_f32_bf16 v108, v12, s85, v108
    v_dot2_f32_bf16 v109, v13, s85, v109
    v_dot2_f32_bf16 v110, v12, s93, v110
    v_dot2_f32_bf16 v111, v13, s93, v111
    v_perm_b32 v12, v61, v60, s46
    v_perm_b32 v13, v61, v60, s47
    v_dot2_f32_bf16 v104, v12, s70, v104
    v_dot2_f32_bf16 v105, v13, s70, v105
    v_dot2_f32_bf16 v106, v12, s78, v106
    v_dot2_f32_bf16 v107, v13, s78, v107
    v_dot2_f32_bf16 v108, v12, s86, v108
    v_dot2_f32_bf16 v109, v13, s86, v109
    v_dot2_f32_bf16 v110, v12, s94, v110
    v_dot2_f32_bf16 v111, v13, s94, v111
    v_perm_b32 v12, v63, v62, s46
    v_perm_b32 v13, v63, v62, s47
    v_dot2_f32_bf16 v104, v12, s71, v104
    v_dot2_f32_bf16 v105, v13, s71, v105
    v_dot2_f32_bf16 v106, v12, s79, v106
    v_dot2_f32_bf16 v107, v13, s79, v107
    v_dot2_f32_bf16 v108, v12, s87, v108
    v_dot2_f32_bf16 v109, v13, s87, v109
    v_dot2_f32_bf16 v110, v12, s95, v110
    v_dot2_f32_bf16 v111, v13, s95, v111
    s_cbranch_execz L_g11
    s_waitcnt vmcnt(4)
L_g11:
    v_perm_b32 v12, v65, v64, s46
    v_perm_b32 v13, v65, v64, s47
    v_dot2_f32_bf16 v104, v12, s72, v104
    v_dot2_f32_bf16 v105, v13, s72, v105
    v_dot2_f32_bf16 v106, v12, s80, v106
    v_dot2_f32_bf16 v107, v13, s80, v107
    v_dot2_f32_bf16 v108, v12, s88, v108
    v_dot2_f32_bf16 v109, v13, s88, v109
    v_dot2_f32_bf16 v110, v12, s96, v110
    v_dot2_f32_bf16 v111, v13, s96, v111
    v_perm_b32 v12, v67, v66, s46
    v_perm_b32 v13, v67, v66, s47
    v_dot2_f32_bf16 v104, v12, s73, v104
    v_dot2_f32_bf16 v105, v13, s73, v105
    v_dot2_f32_bf16 v106, v12, s81, v106
    v_dot2_f32_bf16 v107, v13, s81, v107
    v_dot2_f32_bf16 v108, v12, s89, v108
    v_dot2_f32_bf16 v109, v13, s89, v109
    v_dot2_f32_bf16 v110, v12, s97, v110
    v_dot2_f32_bf16 v111, v13, s97, v111
    v_perm_b32 v12, v69, v68, s46
    v_perm_b32 v13, v69, v68, s47
    v_dot2_f32_bf16 v104, v12, s74, v104
    v_dot2_f32_bf16 v105, v13, s74, v105
    v_dot2_f32_bf16 v106, v12, s82, v106
    v_dot2_f32_bf16 v107, v13, s82, v107
    v_dot2_f32_bf16 v108, v12, s90, v108
    v_dot2_f32_bf16 v109, v13, s90, v109
    v_dot2_f32_bf16 v110, v12, s98, v110
    v_dot2_f32_bf16 v111, v13, s98, v111
    v_perm_b32 v12, v71, v70, s46
    v_perm_b32 v13, v71, v70, s47
    v_dot2_f32_bf16 v104, v12, s75, v104
    v_dot2_f32_bf16 v105, v13, s75, v105
    v_dot2_f32_bf16 v106, v12, s83, v106
    v_dot2_f32_bf16 v107, v13, s83, v107
    v_dot2_f32_bf16 v108, v12, s91, v108
    v_dot2_f32_bf16 v109, v13, s91, v109
    v_dot2_f32_bf16 v110, v12, s99, v110
    v_dot2_f32_bf16 v111, v13, s99, v111
    s_lshl_b32 s49, s26, 11
    v_add_u32 v10, s49, v132
    ds_write_b64 v10, v[104:105] offset:4096
    ds_write_b64 v10, v[106:107] offset:4608
    ds_write_b64 v10, v[108:109] offset:5120
    ds_write_b64 v10, v[110:111] offset:5632
    s_waitcnt lgkmcnt(0)
    s_cbranch_execz L_g12
    s_barrier
L_g12:
    s_cbranch_execz L_dry_done
L_sec4:
    s_lshr_b32 s49, s26, 1
    s_lshl_b32 s55, s49, 3
    v_mov_b32 v18, s55
    v_and_b32 v17, 127, v0
    v_lshlrev_b32 v19, 2, v17
    s_lshl_b32 s55, s49, 9
    v_add_u32 v19, s55, v19
    ds_read_b64 v[40:41], v18 offset:3584
    ds_read_b64 v[42:43], v18 offset:3616
    ds_read_b64 v[44:45], v18 offset:3648
    ds_read_b64 v[46:47], v18 offset:3680
    ds_read_b64 v[48:49], v18 offset:3712
    ds_read_b64 v[50:51], v18 offset:3744
    ds_read_b64 v[52:53], v18 offset:3776
    ds_read_b64 v[54:55], v18 offset:3808
    ds_read_b32 v56, v19 offset:4096
    ds_read_b32 v57, v19 offset:6144
    ds_read_b32 v58, v19 offset:8192
    ds_read_b32 v59, v19 offset:10240
    ds_read_b32 v60, v19 offset:12288
    ds_read_b32 v61, v19 offset:14336
    ds_read_b32 v62, v19 offset:16384
    ds_read_b32 v63, v19 offset:18432
    s_lshr_b32 s49, s26, 1
    s_lshl_b32 s49, s49, 22
    s_lshl_b32 s55, s28, 8
    s_add_u32 s49, s49, s55
    s_add_u32 s49, s49, 8192
    v_lshrrev_b32 v10, 4, v17
    v_lshlrev_b32 v10, 19, v10
    v_and_b32 v8, 15, v17
    v_lshlrev_b32 v8, 3, v8
    v_add3_u32 v10, v10, v8, s49
    v_lshlrev_b32 v11, 19, v17
    v_add_u32 v11, s49, v11
    v_mov_b32 v6, s22
    v_mov_b32 v7, s23
    s_waitcnt lgkmcnt(0)
    v_max3_f32 v4, v40, v42, v44
    v_max3_f32 v4, v4, v46, v48
    v_max3_f32 v4, v4, v50, v52
    v_max_f32 v4, v4, v54
    v_sub_f32 v40, v40, v4
    v_sub_f32 v42, v42, v4
    v_sub_f32 v44, v44, v4
    v_sub_f32 v46, v46, v4
    v_sub_f32 v48, v48, v4
    v_sub_f32 v50, v50, v4
    v_sub_f32 v52, v52, v4
    v_sub_f32 v54, v54, v4
    v_mul_f32 v40, s53, v40
    v_mul_f32 v42, s53, v42
    v_mul_f32 v44, s53, v44
    v_mul_f32 v46, s53, v46
    v_mul_f32 v48, s53, v48
    v_mul_f32 v50, s53, v50
    v_mul_f32 v52, s53, v52
    v_mul_f32 v54, s53, v54
    v_exp_f32 v40, v40
    v_exp_f32 v42, v42
    v_exp_f32 v44, v44
    v_exp_f32 v46, v46
    v_exp_f32 v48, v48
    v_exp_f32 v50, v50
    v_exp_f32 v52, v52
    v_exp_f32 v54, v54
    v_mul_f32 v5, v40, v41
    v_mul_f32 v136, v40, v56
    v_fmac_f32 v5, v42, v43
    v_fmac_f32 v136, v42, v57
    v_fmac_f32 v5, v44, v45
    v_fmac_f32 v136, v44, v58
    v_fmac_f32 v5, v46, v47
    v_fmac_f32 v136, v46, v59
    v_fmac_f32 v5, v48, v49
    v_fmac_f32 v136, v48, v60
    v_fmac_f32 v5, v50, v51
    v_fmac_f32 v136, v50, v61
    v_fmac_f32 v5, v52, v53
    v_fmac_f32 v136, v52, v62
    v_fmac_f32 v5, v54, v55
    v_fmac_f32 v136, v54, v63
    s_nop 1
    v_mov_b32_dpp v137, v136 quad_perm:[1,0,3,2] row_mask:0xf bank_mask:0xf
    v_cmp_gt_u32 vcc, 8, v17
    s_cmp_eq_u32 s63, 0
    s_cbranch_scc0 L_oslow
    s_and_b32 exec_lo, s16, 0x55555555
    s_and_b32 exec_hi, s17, 0x55555555
    s_cbranch_execz L_g13
    global_store_dwordx4 v10, v[136:139], s[56:57]
L_g13:
    s_mov_b64 exec, s[16:17]
    s_and_saveexec_b64 s[50:51], vcc
    s_cbranch_execz L_opub
    s_cbranch_execz L_g14
    global_store_dwordx4 v11, v[4:7], s[56:57] offset:128
L_g14:
    s_branch L_opub
L_oslow:
    s_nop 7
    s_and_b32 exec_lo, s16, 0x55555555
    s_and_b32 exec_hi, s17, 0x55555555
    s_cbranch_execz L_g15
    global_store_dwordx4 v10, v[136:139], s[58:59] sc1
L_g15:
    s_mov_b64 exec, s[16:17]
    s_and_saveexec_b64 s[50:51], vcc
    s_cbranch_execz L_opub
    s_cbranch_execz L_g16
    global_store_dwordx4 v11, v[4:7], s[58:59] offset:128 sc1
L_g16:
L_opub:
    s_nop 7
    s_mov_b64 exec, s[16:17]
    s_cbranch_execz L_g17
    s_waitcnt vmcnt(4)
L_g17:
    v_permlane32_swap_b32 v36, v38
    v_permlane32_swap_b32 v37, v39
    v_perm_b32 v2, v38, v36, s46
    v_perm_b32 v3, v38, v36, s47
    v_perm_b32 v4, v39, v37, s46
    v_perm_b32 v5, v39, v37, s47
    v_dot2_f32_bf16 v112, v2, v26, 0
    v_dot2_f32_bf16 v113, v3, v26, 0
    v_dot2_f32_bf16 v114, v4, v26, 0
    v_dot2_f32_bf16 v115, v5, v26, 0
    v_add_f32_dpp v112, v112, v112 quad_perm:[1,0,3,2] row_mask:0xf bank_mask:0xf
    v_add_f32_dpp v113, v113, v113 quad_perm:[1,0,3,2] row_mask:0xf bank_mask:0xf
    v_add_f32_dpp v114, v114, v114 quad_perm:[1,0,3,2] row_mask:0xf bank_mask:0xf
    v_add_f32_dpp v115, v115, v115 quad_perm:[1,0,3,2] row_mask:0xf bank_mask:0xf
    v_add_f32_dpp v112, v112, v112 quad_perm:[2,3,0,1] row_mask:0xf bank_mask:0xf
    v_add_f32_dpp v113, v113, v113 quad_perm:[2,3,0,1] row_mask:0xf bank_mask:0xf
    v_add_f32_dpp v114, v114, v114 quad_perm:[2,3,0,1] row_mask:0xf bank_mask:0xf
    v_add_f32_dpp v115, v115, v115 quad_perm:[2,3,0,1] row_mask:0xf bank_mask:0xf
    v_add_f32_dpp v112, v112, v112 row_half_mirror row_mask:0xf bank_mask:0xf
    v_add_f32_dpp v113, v113, v113 row_half_mirror row_mask:0xf bank_mask:0xf
    v_add_f32_dpp v114, v114, v114 row_half_mirror row_mask:0xf bank_mask:0xf
    v_add_f32_dpp v115, v115, v115 row_half_mirror row_mask:0xf bank_mask:0xf
    v_add_f32_dpp v112, v112, v112 row_mirror row_mask:0xf bank_mask:0xf
    v_add_f32_dpp v113, v113, v113 row_mirror row_mask:0xf bank_mask:0xf
    v_add_f32_dpp v114, v114, v114 row_mirror row_mask:0xf bank_mask:0xf
    v_add_f32_dpp v115, v115, v115 row_mirror row_mask:0xf bank_mask:0xf
    v_mov_b32 v2, v112
    v_mov_b32 v3, v113
    v_mov_b32 v4, v114
    v_mov_b32 v5, v115
    v_permlane16_swap_b32 v112, v2
    v_permlane16_swap_b32 v113, v3
    v_permlane16_swap_b32 v114, v4
    v_permlane16_swap_b32 v115, v5
    v_add_f32 v112, v112, v2
    v_add_f32 v113, v113, v3
    v_add_f32 v114, v114, v4
    v_add_f32 v115, v115, v5
    v_lshrrev_b32 v2, 5, v1
    v_lshlrev_b32 v4, 4, v2
    s_lshl_b32 s49, s26, 5
    v_add_u32 v4, s49, v4
    s_and_b32 exec_lo, s16, 0x1
    s_and_b32 exec_hi, s17, 0x1
    ds_write_b128 v4, v[112:115] offset:3328
    s_mov_b64 exec, s[16:17]
    s_cbranch_execz L_dry_done
L_sec5:
    s_cbranch_execz L_g18
    s_waitcnt vmcnt(0) lgkmcnt(0)
    s_barrier
L_g18:
    s_lshl_b32 s55, s26, 2
    v_mov_b32 v16, s55
    ds_read_b32 v64, v16 offset:3328
    ds_read_b32 v65, v16 offset:3360
    ds_read_b32 v66, v16 offset:3392
    ds_read_b32 v67, v16 offset:3424
    ds_read_b32 v68, v16 offset:3456
    ds_read_b32 v69, v16 offset:3488
    ds_read_b32 v70, v16 offset:3520
    ds_read_b32 v71, v16 offset:3552
    ds_read_b64 v[40:41], v130 offset:57408
    ds_read_b64 v[42:43], v131 offset:57344
    s_waitcnt lgkmcnt(0)
    v_add_f32 v64, v64, v65
    v_add_f32 v66, v66, v67
    v_add_f32 v68, v68, v69
    v_add_f32 v70, v70, v71
    v_add_f32 v64, v64, v66
    v_add_f32 v68, v68, v70
    v_add_f32 v18, v64, v68
    v_cvt_pk_bf16_f32 v19, v18, v18
    v_lshlrev_b32 v18, 16, v19
    v_max_f32 v18, 0, v18
    v_and_b32 v18, s48, v18
    v_mov_b32 v2, v40
    s_nop 1
    v_max_f32_dpp v2, v2, v2 quad_perm:[1,0,3,2] row_mask:0xf bank_mask:0xf
    s_nop 1
    v_max_f32_dpp v2, v2, v2 quad_perm:[2,3,0,1] row_mask:0xf bank_mask:0xf
    s_nop 1
    v_max_f32_dpp v2, v2, v2 row_half_mirror row_mask:0xf bank_mask:0xf
    s_nop 1
    v_max_f32_dpp v2, v2, v2 row_mirror row_mask:0xf bank_mask:0xf
    v_mov_b32 v3, v2
    s_nop 1
    v_permlane16_swap_b32 v2, v3
    v_max_f32 v2, v2, v3
    v_sub_f32 v2, v40, v2
    v_mul_f32 v2, s53, v2
    v_exp_f32 v2, v2
    s_nop 0
    v_mul_f32 v3, v2, v41
    v_mul_f32 v4, v2, v42
    v_mul_f32 v5, v2, v43
    v_add_f32_dpp v3, v3, v3 quad_perm:[1,0,3,2] row_mask:0xf bank_mask:0xf
    v_add_f32_dpp v4, v4, v4 quad_perm:[1,0,3,2] row_mask:0xf bank_mask:0xf
    v_add_f32_dpp v5, v5, v5 quad_perm:[1,0,3,2] row_mask:0xf bank_mask:0xf
    v_add_f32_dpp v3, v3, v3 quad_perm:[2,3,0,1] row_mask:0xf bank_mask:0xf
    v_add_f32_dpp v4, v4, v4 quad_perm:[2,3,0,1] row_mask:0xf bank_mask:0xf
    v_add_f32_dpp v5, v5, v5 quad_perm:[2,3,0,1] row_mask:0xf bank_mask:0xf
    v_add_f32_dpp v3, v3, v3 row_half_mirror row_mask:0xf bank_mask:0xf
    v_add_f32_dpp v4, v4, v4 row_half_mirror row_mask:0xf bank_mask:0xf
    v_add_f32_dpp v5, v5, v5 row_half_mirror row_mask:0xf bank_mask:0xf
    v_add_f32_dpp v3, v3, v3 row_mirror row_mask:0xf bank_mask:0xf
    v_add_f32_dpp v4, v4, v4 row_mirror row_mask:0xf bank_mask:0xf
    v_add_f32_dpp v5, v5, v5 row_mirror row_mask:0xf bank_mask:0xf
    v_mov_b32 v6, v3
    v_mov_b32 v7, v4
    v_mov_b32 v8, v5
    v_permlane16_swap_b32 v3, v6
    v_permlane16_swap_b32 v4, v7
    v_permlane16_swap_b32 v5, v8
    v_add_f32 v3, v3, v6
    v_add_f32 v4, v4, v7
    v_add_f32 v5, v5, v8
    v_rcp_f32 v6, v3
    s_nop 0
    v_fma_f32 v7, -v3, v6, 1.0
    v_fma_f32 v6, v7, v6, v6
    v_mul_f32 v4, v4, v6
    v_mul_f32 v5, v5, v6
    v_cvt_pk_bf16_f32 v2, v4, v5
    v_perm_b32 v4, v76, v72, s46
    v_perm_b32 v5, v76, v72, s47
    v_perm_b32 v6, v77, v73, s46
    v_perm_b32 v7, v77, v73, s47
    v_perm_b32 v8, v78, v74, s46
    v_perm_b32 v9, v78, v74, s47
    v_perm_b32 v10, v79, v75, s46
    v_perm_b32 v11, v79, v75, s47
    v_dot2_f32_bf16 v104, v4, v2, 0
    v_dot2_f32_bf16 v105, v5, v2, 0
    v_dot2_f32_bf16 v106, v6, v2, 0
    v_dot2_f32_bf16 v107, v7, v2, 0
    v_dot2_f32_bf16 v108, v8, v2, 0
    v_dot2_f32_bf16 v109, v9, v2, 0
    v_dot2_f32_bf16 v110, v10, v2, 0
    v_dot2_f32_bf16 v111, v11, v2, 0
    v_lshlrev_b32 v112, 16, v80
    v_and_b32 v113, 0xffff0000, v80
    v_lshlrev_b32 v114, 16, v81
    v_and_b32 v115, 0xffff0000, v81
    v_lshlrev_b32 v116, 16, v82
    v_and_b32 v117, 0xffff0000, v82
    v_lshlrev_b32 v118, 16, v83
    v_and_b32 v119, 0xffff0000, v83
    v_mul_f32 v112, v112, v18
    v_mul_f32 v113, v113, v18
    v_mul_f32 v114, v114, v18
    v_mul_f32 v115, v115, v18
    v_mul_f32 v116, v116, v18
    v_mul_f32 v117, v117, v18
    v_mul_f32 v118, v118, v18
    v_mul_f32 v119, v119, v18
    v_lshlrev_b32 v12, 5, v1
    s_lshl_b32 s49, s26, 12
    v_add_u32 v12, s49, v12
    ds_write_b128 v12, v[104:107] offset:20480
    ds_write_b128 v12, v[108:111] offset:20496
    ds_write_b128 v12, v[112:115] offset:22528
    ds_write_b128 v12, v[116:119] offset:22544
    s_waitcnt lgkmcnt(0)
    s_cbranch_execz L_g19
    s_barrier
L_g19:
    v_lshlrev_b32 v18, 2, v0
    ds_read_b32 v40, v18 offset:20480
    ds_read_b32 v48, v18 offset:22528
    ds_read_b32 v41, v18 offset:24576
    ds_read_b32 v49, v18 offset:26624
    ds_read_b32 v42, v18 offset:28672
    ds_read_b32 v50, v18 offset:30720
    ds_read_b32 v43, v18 offset:32768
    ds_read_b32 v51, v18 offset:34816
    ds_read_b32 v44, v18 offset:36864
    ds_read_b32 v52, v18 offset:38912
    ds_read_b32 v45, v18 offset:40960
    ds_read_b32 v53, v18 offset:43008
    ds_read_b32 v46, v18 offset:45056
    ds_read_b32 v54, v18 offset:47104
    ds_read_b32 v47, v18 offset:49152
    ds_read_b32 v55, v18 offset:51200
    v_lshrrev_b32 v8, 4, v0
    v_lshlrev_b32 v8, 19, v8
    v_and_b32 v9, 15, v0
    v_lshlrev_b32 v9, 4, v9
    s_lshl_b32 s49, s28, 8
    s_add_u32 s49, s49, 16384
    v_add3_u32 v8, v8, v9, s49
    s_waitcnt lgkmcnt(0)
    v_add_f32 v40, v40, v41
    v_add_f32 v42, v42, v43
    v_add_f32 v44, v44, v45
    v_add_f32 v46, v46, v47
    v_add_f32 v40, v40, v42
    v_add_f32 v44, v44, v46
    v_add_f32 v136, v40, v44
    v_add_f32 v48, v48, v49
    v_add_f32 v50, v50, v51
    v_add_f32 v52, v52, v53
    v_add_f32 v54, v54, v55
    v_add_f32 v48, v48, v50
    v_add_f32 v52, v52, v54
    v_add_f32 v137, v48, v52
    s_cmp_eq_u32 s63, 0
    s_cbranch_scc0 L_faslow
    s_cbranch_execz L_g20
    global_store_dwordx4 v8, v[136:139], s[56:57]
L_g20:
    s_branch L_fapub
L_faslow:
    s_nop 7
    s_cbranch_execz L_g21
    global_store_dwordx4 v8, v[136:139], s[58:59] sc1
L_g21:
L_fapub:
    s_nop 7
    s_cbranch_execz L_dry_done
    s_branch L_end
L_comm:
    s_nop 7
L_sec6:
    v_mov_b32 v14, 0
    v_mov_b32 v15, 0
    v_mov_b32 v16, 0
    v_mov_b32 v17, 0
    s_lshl_b32 s49, s28, 8
    s_add_u32 s50, s49, 8192
    s_add_u32 s51, s49, 16384
    s_cbranch_execz L_g22
    s_waitcnt vmcnt(0)
L_g22:
    v_readfirstlane_b32 s22, v27
    s_nop 1
    s_add_u32 s22, s22, 1
    s_xor_b32 s23, s22, 0xa5c3a5c0
    s_xor_b32 s15, s23, s14
    v_mov_b32 v138, s22
    v_mov_b32 v139, s23
    s_cbranch_execz L_g23
    s_barrier
    s_barrier
L_g23:
    v_add_u32 v13, s50, v123
    s_cbranch_execz L_g24
    global_store_dwordx4 v13, v[14:17], s[56:57]
L_g24:
    s_nop 1
    v_add_u32 v13, 2097152, v13
    s_cbranch_execz L_g25
    global_store_dwordx4 v13, v[14:17], s[56:57]
L_g25:
    s_nop 1
    v_add_u32 v13, 2097152, v13
    s_cbranch_execz L_g26
    global_store_dwordx4 v13, v[14:17], s[56:57]
L_g26:
    s_nop 1
    v_add_u32 v13, 2097152, v13
    s_cbranch_execz L_g27
    global_store_dwordx4 v13, v[14:17], s[56:57]
L_g27:
    s_nop 1
    v_add_u32 v13, 2097152, v13
    s_cbranch_execz L_g28
    global_store_dwordx4 v13, v[14:17], s[56:57]
L_g28:
    s_nop 1
    v_add_u32 v13, 2097152, v13
    s_cbranch_execz L_g29
    global_store_dwordx4 v13, v[14:17], s[56:57]
L_g29:
    s_nop 1
    v_add_u32 v13, 2097152, v13
    s_cbranch_execz L_g30
    global_store_dwordx4 v13, v[14:17], s[56:57]
L_g30:
    s_nop 1
    v_add_u32 v13, 2097152, v13
    s_cbranch_execz L_g31
    global_store_dwordx4 v13, v[14:17], s[56:57]
L_g31:
    s_nop 1
    v_add_u32 v13, s51, v123
    s_cbranch_execz L_g32
    global_store_dwordx4 v13, v[14:17], s[56:57]
L_g32:
    s_nop 1
    v_add_u32 v13, 2097152, v13
    s_cbranch_execz L_g33
    global_store_dwordx4 v13, v[14:17], s[56:57]
L_g33:
    s_nop 1
    v_add_u32 v13, 2097152, v13
    s_cbranch_execz L_g34
    global_store_dwordx4 v13, v[14:17], s[56:57]
L_g34:
    s_nop 1
    v_add_u32 v13, 2097152, v13
    s_cbranch_execz L_g35
    global_store_dwordx4 v13, v[14:17], s[56:57]
L_g35:
    s_nop 1
    v_add_u32 v13, 2097152, v13
    s_cbranch_execz L_g36
    global_store_dwordx4 v13, v[14:17], s[56:57]
L_g36:
    s_nop 1
    v_add_u32 v13, 2097152, v13
    s_cbranch_execz L_g37
    global_store_dwordx4 v13, v[14:17], s[56:57]
L_g37:
    s_nop 1
    v_add_u32 v13, 2097152, v13
    s_cbranch_execz L_g38
    global_store_dwordx4 v13, v[14:17], s[56:57]
L_g38:
    s_nop 1
    v_add_u32 v13, 2097152, v13
    s_cbranch_execz L_g39
    global_store_dwordx4 v13, v[14:17], s[56:57]
    s_barrier
    global_load_dwordx4 v[40:43], v120, s[56:57] offset:0 sc1
    global_load_dwordx4 v[44:47], v120, s[56:57] offset:1024 sc1
    global_load_dwordx4 v[48:51], v120, s[56:57] offset:2048 sc1
    global_load_dwordx4 v[52:55], v120, s[56:57] offset:3072 sc1
    global_load_dwordx4 v[56:59], v126, s[56:57] offset:0 sc1
    global_load_dwordx4 v[60:63], v126, s[56:57] offset:1024 sc1
    global_load_dwordx4 v[64:67], v126, s[56:57] offset:2048 sc1
    global_load_dwordx4 v[68:71], v126, s[56:57] offset:3072 sc1
    s_barrier
    s_waitcnt vmcnt(0)
L_g39:
    s_cbranch_execz L_dry_done
L_secB5:
    v_xor_b32 v3, s22, v42
    v_xor_b32 v4, s15, v43
    v_mov_b32 v5, v4
    v_mov_b32 v2, v3
    v_xor_b32 v3, s22, v46
    v_xor_b32 v4, s15, v47
    v_or_b32 v5, v5, v4
    v_or_b32 v2, v2, v3
    v_xor_b32 v3, s22, v50
    v_xor_b32 v4, s15, v51
    v_or_b32 v5, v5, v4
    v_or_b32 v2, v2, v3
    v_xor_b32 v3, s22, v54
    v_xor_b32 v4, s15, v55
    v_or_b32 v5, v5, v4
    v_or_b32 v2, v2, v3
    v_xor_b32 v3, s22, v58
    v_xor_b32 v4, s15, v59
    v_or_b32 v5, v5, v4
    v_or_b32 v2, v2, v3
    v_xor_b32 v3, s22, v62
    v_xor_b32 v4, s15, v63
    v_or_b32 v5, v5, v4
    v_or_b32 v2, v2, v3
    v_xor_b32 v3, s22, v66
    v_xor_b32 v4, s15, v67
    v_or_b32 v5, v5, v4
    v_or_b32 v2, v2, v3
    v_xor_b32 v3, s22, v70
    v_xor_b32 v4, s15, v71
    v_or_b32 v5, v5, v4
    v_or_b32 v2, v2, v3
    v_and_b32 v4, -8, v5
    v_or_b32 v2, v2, v4
    v_cmp_ne_u32 vcc, 0, v2
    s_nop 1
    s_cmp_eq_u64 vcc, 0
    s_cbranch_scc1 L_q_ok
L_q_loop:
    s_nop 7
    s_cbranch_execz L_g40
    global_load_dwordx4 v[40:43], v120, s[56:57] offset:0 sc1
    global_load_dwordx4 v[44:47], v120, s[56:57] offset:1024 sc1
    global_load_dwordx4 v[48:51], v120, s[56:57] offset:2048 sc1
    global_load_dwordx4 v[52:55], v120, s[56:57] offset:3072 sc1
    global_load_dwordx4 v[56:59], v126, s[56:57] offset:0 sc1
    global_load_dwordx4 v[60:63], v126, s[56:57] offset:1024 sc1
    global_load_dwordx4 v[64:67], v126, s[56:57] offset:2048 sc1
    global_load_dwordx4 v[68:71], v126, s[56:57] offset:3072 sc1
L_g40:
    s_add_u32 s52, s52, 1
    s_cmp_gt_u32 s52, 400000
    s_cbranch_scc1 L_end
    s_cbranch_execz L_g41
    s_waitcnt vmcnt(0)
L_g41:
    v_xor_b32 v3, s22, v42
    v_xor_b32 v4, s15, v43
    v_mov_b32 v5, v4
    v_mov_b32 v2, v3
    v_xor_b32 v3, s22, v46
    v_xor_b32 v4, s15, v47
    v_or_b32 v5, v5, v4
    v_or_b32 v2, v2, v3
    v_xor_b32 v3, s22, v50
    v_xor_b32 v4, s15, v51
    v_or_b32 v5, v5, v4
    v_or_b32 v2, v2, v3
    v_xor_b32 v3, s22, v54
    v_xor_b32 v4, s15, v55
    v_or_b32 v5, v5, v4
    v_or_b32 v2, v2, v3
    v_xor_b32 v3, s22, v58
    v_xor_b32 v4, s15, v59
    v_or_b32 v5, v5, v4
    v_or_b32 v2, v2, v3
    v_xor_b32 v3, s22, v62
    v_xor_b32 v4, s15, v63
    v_or_b32 v5, v5, v4
    v_or_b32 v2, v2, v3
    v_xor_b32 v3, s22, v66
    v_xor_b32 v4, s15, v67
    v_or_b32 v5, v5, v4
    v_or_b32 v2, v2, v3
    v_xor_b32 v3, s22, v70
    v_xor_b32 v4, s15, v71
    v_or_b32 v5, v5, v4
    v_or_b32 v2, v2, v3
    v_and_b32 v4, -8, v5
    v_or_b32 v2, v2, v4
    v_cmp_ne_u32 vcc, 0, v2
    s_nop 1
    s_cmp_eq_u64 vcc, 0
    s_cbranch_scc1 L_q_ok
    s_and_b32 s49, s52, 3
    s_cmp_lg_u32 s49, 3
    s_cbranch_scc1 L_q_loop
    s_cbranch_execz L_g42
    global_load_dwordx4 v[40:43], v120, s[58:59] offset:0 sc1
    global_load_dwordx4 v[44:47], v120, s[58:59] offset:1024 sc1
    global_load_dwordx4 v[48:51], v120, s[58:59] offset:2048 sc1
    global_load_dwordx4 v[52:55], v120, s[58:59] offset:3072 sc1
    global_load_dwordx4 v[56:59], v126, s[58:59] offset:0 sc1
    global_load_dwordx4 v[60:63], v126, s[58:59] offset:1024 sc1
    global_load_dwordx4 v[64:67], v126, s[58:59] offset:2048 sc1
    global_load_dwordx4 v[68:71], v126, s[58:59] offset:3072 sc1
    s_waitcnt vmcnt(0)
L_g42:
    v_xor_b32 v3, s22, v42
    v_xor_b32 v4, s15, v43
    v_mov_b32 v5, v4
    v_mov_b32 v2, v3
    v_xor_b32 v3, s22, v46
    v_xor_b32 v4, s15, v47
    v_or_b32 v5, v5, v4
    v_or_b32 v2, v2, v3
    v_xor_b32 v3, s22, v50
    v_xor_b32 v4, s15, v51
    v_or_b32 v5, v5, v4
    v_or_b32 v2, v2, v3
    v_xor_b32 v3, s22, v54
    v_xor_b32 v4, s15, v55
    v_or_b32 v5, v5, v4
    v_or_b32 v2, v2, v3
    v_xor_b32 v3, s22, v58
    v_xor_b32 v4, s15, v59
    v_or_b32 v5, v5, v4
    v_or_b32 v2, v2, v3
    v_xor_b32 v3, s22, v62
    v_xor_b32 v4, s15, v63
    v_or_b32 v5, v5, v4
    v_or_b32 v2, v2, v3
    v_xor_b32 v3, s22, v66
    v_xor_b32 v4, s15, v67
    v_or_b32 v5, v5, v4
    v_or_b32 v2, v2, v3
    v_xor_b32 v3, s22, v70
    v_xor_b32 v4, s15, v71
    v_or_b32 v5, v5, v4
    v_or_b32 v2, v2, v3
    v_and_b32 v4, -8, v5
    v_or_b32 v2, v2, v4
    v_cmp_ne_u32 vcc, 0, v2
    s_nop 1
    s_cmp_eq_u64 vcc, 0
    s_cbranch_scc0 L_q_loop
L_q_ok:
    s_nop 7
    ds_write_b64 v132, v[40:41] offset:53248
    ds_write_b64 v132, v[44:45] offset:53760
    ds_write_b64 v132, v[48:49] offset:54272
    ds_write_b64 v132, v[52:53] offset:54784
    ds_write_b64 v132, v[56:57] offset:55296
    ds_write_b64 v132, v[60:61] offset:55808
    ds_write_b64 v132, v[64:65] offset:56320
    ds_write_b64 v132, v[68:69] offset:56832
    v_cmp_ne_u32 vcc, 0, v5
    s_nop 1
    s_cmp_eq_u64 vcc, 0
    s_cselect_b32 s63, 0, 1
    v_mov_b32 v2, 0
    v_mov_b32 v3, s63
    ds_write_b32 v2, v3 offset:3200
    s_cmp_eq_u32 s63, 0
    s_cselect_b32 s64, s30, s34
    s_cselect_b32 s65, s31, s35
    s_cselect_b32 s66, s32, s60
    s_cselect_b32 s67, s33, s61
    s_waitcnt lgkmcnt(0)
    s_cbranch_execz L_g43
    s_barrier
L_g43:
    s_cbranch_execz L_dry_done
L_sec7:
    s_cbranch_execz L_g44
    s_barrier
L_g44:
L_o_loop:
    s_nop 7
    s_cbranch_execz L_g45
    global_load_dwordx4 v[40:43], v134, s[64:65] offset:0 sc1
    global_load_dwordx4 v[44:47], v134, s[64:65] offset:1024 sc1
    global_load_dwordx4 v[48:51], v134, s[64:65] offset:2048 sc1
    global_load_dwordx4 v[52:55], v134, s[64:65] offset:3072 sc1
    global_load_dwordx4 v[56:59], v134, s[66:67] offset:0 sc1
    global_load_dwordx4 v[60:63], v134, s[66:67] offset:1024 sc1
    global_load_dwordx4 v[64:67], v134, s[66:67] offset:2048 sc1
    global_load_dwordx4 v[68:71], v134, s[66:67] offset:3072 sc1
L_g45:
    s_add_u32 s52, s52, 1
    s_cmp_gt_u32 s52, 400000
    s_cbranch_scc1 L_end
    s_cbranch_execz L_g46
    s_waitcnt vmcnt(0)
L_g46:
    v_xor_b32 v2, s22, v42
    v_xor_b32 v3, s23, v43
    v_or_b32 v2, v2, v3
    v_xor_b32 v3, s22, v46
    v_xor_b32 v4, s23, v47
    v_or3_b32 v2, v2, v3, v4
    v_xor_b32 v3, s22, v50
    v_xor_b32 v4, s23, v51
    v_or3_b32 v2, v2, v3, v4
    v_xor_b32 v3, s22, v54
    v_xor_b32 v4, s23, v55
    v_or3_b32 v2, v2, v3, v4
    v_xor_b32 v3, s22, v58
    v_xor_b32 v4, s23, v59
    v_or3_b32 v2, v2, v3, v4
    v_xor_b32 v3, s22, v62
    v_xor_b32 v4, s23, v63
    v_or3_b32 v2, v2, v3, v4
    v_xor_b32 v3, s22, v66
    v_xor_b32 v4, s23, v67
    v_or3_b32 v2, v2, v3, v4
    v_xor_b32 v3, s22, v70
    v_xor_b32 v4, s23, v71
    v_or3_b32 v2, v2, v3, v4
    v_cmp_ne_u32 vcc, 0, v2
    s_nop 1
    s_cmp_eq_u64 vcc, 0
    s_cbranch_scc0 L_o_loop
L_o_ok:
    s_nop 7
    ds_write_b64 v133, v[40:41] offset:57344
    ds_write_b64 v133, v[44:45] offset:57856
    ds_write_b64 v133, v[48:49] offset:58368
    ds_write_b64 v133, v[52:53] offset:58880
    ds_write_b64 v133, v[56:57] offset:59392
    ds_write_b64 v133, v[60:61] offset:59904
    ds_write_b64 v133, v[64:65] offset:60416
    ds_write_b64 v133, v[68:69] offset:60928
    s_waitcnt lgkmcnt(0)
    s_cbranch_execz L_g47
    s_barrier
    s_barrier
L_g47:
    s_cbranch_execz L_dry_done
L_secB7:
L_fa_loop:
    s_nop 7
    s_cbranch_execz L_g48
    global_load_dwordx4 v[40:43], v135, s[64:65] offset:0 sc1
    global_load_dwordx4 v[44:47], v135, s[64:65] offset:1024 sc1
    global_load_dwordx4 v[48:51], v135, s[64:65] offset:2048 sc1
    global_load_dwordx4 v[52:55], v135, s[64:65] offset:3072 sc1
    global_load_dwordx4 v[56:59], v135, s[66:67] offset:0 sc1
    global_load_dwordx4 v[60:63], v135, s[66:67] offset:1024 sc1
    global_load_dwordx4 v[64:67], v135, s[66:67] offset:2048 sc1
    global_load_dwordx4 v[68:71], v135, s[66:67] offset:3072 sc1
L_g48:
    s_add_u32 s52, s52, 1
    s_cmp_gt_u32 s52, 400000
    s_cbranch_scc1 L_end
    s_cbranch_execz L_g49
    s_waitcnt vmcnt(0)
L_g49:
    v_xor_b32 v2, s22, v42
    v_xor_b32 v3, s23, v43
    v_or_b32 v2, v2, v3
    v_xor_b32 v3, s22, v46
    v_xor_b32 v4, s23, v47
    v_or3_b32 v2, v2, v3, v4
    v_xor_b32 v3, s22, v50
    v_xor_b32 v4, s23, v51
    v_or3_b32 v2, v2, v3, v4
    v_xor_b32 v3, s22, v54
    v_xor_b32 v4, s23, v55
    v_or3_b32 v2, v2, v3, v4
    v_xor_b32 v3, s22, v58
    v_xor_b32 v4, s23, v59
    v_or3_b32 v2, v2, v3, v4
    v_xor_b32 v3, s22, v62
    v_xor_b32 v4, s23, v63
    v_or3_b32 v2, v2, v3, v4
    v_xor_b32 v3, s22, v66
    v_xor_b32 v4, s23, v67
    v_or3_b32 v2, v2, v3, v4
    v_xor_b32 v3, s22, v70
    v_xor_b32 v4, s23, v71
    v_or3_b32 v2, v2, v3, v4
    v_cmp_ne_u32 vcc, 0, v2
    s_nop 1
    s_cmp_eq_u64 vcc, 0
    s_cbranch_scc0 L_fa_loop
L_fa_ok:
    s_nop 7
    v_add_f32 v40, v40, v44
    v_add_f32 v48, v48, v52
    v_add_f32 v56, v56, v60
    v_add_f32 v64, v64, v68
    v_add_f32 v40, v40, v48
    v_add_f32 v56, v56, v64
    v_add_f32 v136, v40, v56
    v_add_f32 v41, v41, v45
    v_add_f32 v49, v49, v53
    v_add_f32 v57, v57, v61
    v_add_f32 v65, v65, v69
    v_add_f32 v41, v41, v49
    v_add_f32 v57, v57, v65
    v_add_f32 v137, v41, v57
    v_mov_b32 v2, v136
    v_mov_b32 v3, v137
    s_nop 0
    v_permlane16_swap_b32 v136, v2
    v_permlane16_swap_b32 v137, v3
    v_add_f32 v136, v136, v2
    v_add_f32 v137, v137, v3
    v_mov_b32 v2, v136
    v_mov_b32 v3, v137
    s_nop 0
    v_permlane32_swap_b32 v136, v2
    v_permlane32_swap_b32 v137, v3
    v_add_f32 v136, v136, v2
    v_add_f32 v137, v137, v3
    s_lshl_b32 s49, s27, 8
    s_add_u32 s49, s49, s3
    s_add_u32 s49, s49, 24576
    v_add_u32 v2, s49, v120
    s_and_b32 exec_lo, s16, 0xffff
    s_and_b32 exec_hi, s17, 0x0
    s_cbranch_execz L_g50
    global_store_dwordx4 v2, v[136:139], s[24:25] sc1
L_g50:
    s_mov_b64 exec, s[16:17]
    s_and_b32 s49, s28, 7
    s_cmp_lg_u32 s49, s27
    s_cbranch_scc1 L_fin
    v_lshlrev_b32 v12, 1, v1
    s_lshl_b32 s49, s28, 5
    v_add_u32 v12, s49, v12
    s_and_b32 exec_lo, s16, 0xffff
    s_and_b32 exec_hi, s17, 0x0
    s_cbranch_execz L_g51
    global_load_ushort v14, v12, s[4:5]
L_g51:
    s_mov_b64 exec, s[16:17]
    v_add_u32 v13, 24576, v120
L_fb_loop:
    s_nop 7
    s_cbranch_execz L_g52
    global_load_dwordx4 v[40:43], v13, s[30:31] offset:0 sc1
    global_load_dwordx4 v[44:47], v13, s[30:31] offset:1024 sc1
L_g52:
    s_add_u32 s52, s52, 1
    s_cmp_gt_u32 s52, 400000
    s_cbranch_scc1 L_end
    s_cbranch_execz L_g53
    s_waitcnt vmcnt(0)
L_g53:
    v_xor_b32 v2, s22, v42
    v_xor_b32 v3, s23, v43
    v_or_b32 v2, v2, v3
    v_xor_b32 v3, s22, v46
    v_xor_b32 v4, s23, v47
    v_or3_b32 v2, v2, v3, v4
    v_cmp_ne_u32 vcc, 0, v2
    s_nop 1
    s_cmp_eq_u64 vcc, 0
    s_cbranch_scc0 L_fb_loop
L_fb_ok:
    s_nop 7
    v_add_f32 v136, v40, v44
    v_add_f32 v137, v41, v45
    v_mov_b32 v2, v136
    v_mov_b32 v3, v137
    s_nop 0
    v_permlane16_swap_b32 v136, v2
    v_permlane16_swap_b32 v137, v3
    v_add_f32 v136, v136, v2
    v_add_f32 v137, v137, v3
    v_mov_b32 v2, v136
    v_mov_b32 v3, v137
    s_nop 0
    v_permlane32_swap_b32 v136, v2
    v_permlane32_swap_b32 v137, v3
    v_add_f32 v136, v136, v2
    v_add_f32 v137, v137, v3
    v_cvt_pk_bf16_f32 v2, v136, v137
    v_lshlrev_b32 v3, 16, v2
    v_and_b32 v4, 0xffff0000, v2
    v_lshlrev_b32 v5, 16, v14
    v_add_f32 v3, v3, v5
    v_cvt_pk_bf16_f32 v6, v3, v3
    v_lshlrev_b32 v3, 16, v6
    v_add_f32 v3, v3, v4
    v_cvt_pk_bf16_f32 v2, v3, v3
    s_and_b32 exec_lo, s16, 0xffff
    s_and_b32 exec_hi, s17, 0x0
    s_cbranch_execz L_g54
    global_store_short v12, v2, s[20:21]
L_g54:
    s_mov_b64 exec, s[16:17]
    s_cmp_lg_u32 s2, 0
    s_cbranch_scc1 L_fin
    v_mov_b32 v3, 0x1800000
    v_mov_b32 v4, s22
    s_and_b32 exec_lo, s16, 0x1
    s_and_b32 exec_hi, s17, 0x0
    s_cbranch_execz L_g55
    global_store_dword v3, v4, s[24:25]
L_g55:
    s_mov_b64 exec, s[16:17]
L_fin:
    s_nop 7
    s_cbranch_execz L_dry_done
L_end:
    s_nop 7
    s_endpgm
.section .rodata,"a"
.p2align 6
.amdhsa_kernel parallel_sum__sliding_block_cached__dense_activation_relu__decode_kernel
  .amdhsa_next_free_vgpr 140
  .amdhsa_next_free_sgpr 102
  .amdhsa_accum_offset 140
  .amdhsa_group_segment_fixed_size 0
  .amdhsa_kernarg_size 88
  .amdhsa_user_sgpr_count 2
  .amdhsa_user_sgpr_kernarg_segment_ptr 1
  .amdhsa_system_sgpr_workgroup_id_x 1
  .amdhsa_float_denorm_mode_32 3
  .amdhsa_float_denorm_mode_16_64 3
.end_amdhsa_kernel
```
